```python
import torch

def _softmax(x, axis=-1):
    return torch.softmax(x, dim=axis)
def _gelu(x):
    return torch.nn.functional.gelu(x, approximate="tanh")
def _silu(x):
    return torch.nn.functional.silu(x)
def _sigmoid(x):
    return torch.sigmoid(x)
def _layernorm(x, axis=-1, eps=1e-5):
    m = x.mean(dim=axis, keepdim=True)
    v = x.var(dim=axis, keepdim=True, unbiased=False)
    return (x - m) / torch.sqrt(v + eps)
def _scatter_add(tgt, idx, src, axis=0):
    return tgt.clone().index_add_(axis, idx, src)
def _segment_sum(src, seg, n):
    out = torch.zeros((n,) + src.shape[1:], dtype=src.dtype)
    return out.index_add_(0, seg, src)
def _pad(x, pw):
    flat = tuple(v for pair in reversed(pw) for v in pair)
    return torch.nn.functional.pad(x, flat)

kernel_name = 'standalone__gqa_block_cached__near_ridge'

def setup_inputs():

    _w = (lambda a: (lambda t: t.to(torch.bfloat16) if t.is_floating_point() else t)(torch.as_tensor(a)))
    B, Sq, D = 8, 64, 512
    Hq, Hkv, Sk, Dh = 32, 8, 512, 128
    assert Hq % Hkv == 0, (Hq, Hkv)
    return {
        "x": _w((lambda *s: torch.randn(*s, dtype=torch.bfloat16) * 0.8)(B, Sq, D)),
        "k_cache": _w((lambda *s: torch.randn(*s, dtype=torch.bfloat16) * 0.8)(B, Hkv, Sk, Dh)),
        "v_cache": _w((lambda *s: torch.randn(*s, dtype=torch.bfloat16) * 0.05)(B, Hkv, Sk, Dh)),
        "wq": _w((lambda *s: torch.randn(*s, dtype=torch.bfloat16) * 0.8)(D, Hq * Dh) * (D ** -0.5)),
        "wo": _w((lambda *s: torch.randn(*s, dtype=torch.bfloat16) * 0.05)(Hq * Dh, D) * ((Hq * Dh) ** -0.5)),
    }

def reference(x, k_cache, v_cache, wq, wo):
    B, Sq, D = x.shape
    Hq, Dh = 32, 128
    Hkv = k_cache.shape[1]
    rep = Hq // Hkv
    q = (lambda x, *d: x.permute(*d))((x @ wq).reshape(B, Sq, Hq, Dh), 0, 2, 1, 3)
    k = (lambda x, n, axis: torch.repeat_interleave(x, n, dim=axis))(k_cache, rep, axis=1)
    v = (lambda x, n, axis: torch.repeat_interleave(x, n, dim=axis))(v_cache, rep, axis=1)
    scores = torch.einsum("bhqd,bhkd->bhqk", q, k) * (Dh ** -0.5)
    p = _softmax(scores, axis=-1)
    o = torch.einsum("bhqk,bhkd->bhqd", p, v)
    return (lambda x, *d: x.permute(*d))(o, 0, 2, 1, 3).reshape(B, Sq, Hq * Dh) @ wo
```

```asm
; @launch kernel=attn_kernel grid=(256,1,1) block=(512,1,1) lds=163840
; @launch kernel=oproj_kernel grid=(256,1,1) block=(256,1,1) lds=16384
.amdgcn_target "amdgcn-amd-amdhsa--gfx950"
.text
.globl attn_kernel
.p2align 8
.type attn_kernel,@function
attn_kernel:
    s_cmp_ge_u32 s2, 256
    s_cbranch_scc1 L1_done
    s_load_dwordx16 s[4:19], s[0:1], 0
    s_and_b32 s44, s2, 7
    s_lshr_b32 s45, s2, 3
    s_lshr_b32 s46, s45, 2
    s_and_b32 s47, s45, 3
    s_lshl_b32 s48, s44, 2
    s_add_u32 s48, s48, s47
    v_lshrrev_b32 v1, 6, v0
    v_and_b32 v2, 63, v0
    v_readfirstlane_b32 s49, v1
    v_and_b32 v50, 3, v1
    v_lshrrev_b32 v51, 2, v1
    v_lshrrev_b32 v3, 4, v2
    v_and_b32 v4, 15, v2
    v_lshlrev_b32 v5, 2, v3
    v_xor_b32 v5, v4, v5
    v_lshlrev_b32 v5, 4, v5
    v_lshl_add_u32 v8, v3, 13, v5
    v_lshl_add_u32 v9, v3, 8, v5
    v_lshl_add_u32 v6, v50, 2, v3
    v_xor_b32 v6, v4, v6
    v_lshlrev_b32 v6, 4, v6
    v_lshl_add_u32 v10, v3, 8, v6
    v_lshrrev_b32 v6, 3, v2
    v_and_b32 v7, 7, v2
    v_and_b32 v36, 1, v1
    v_lshl_add_u32 v36, v36, 2, v3
    v_and_b32 v36, 7, v36
    v_xor_b32 v36, v7, v36
    v_lshlrev_b32 v36, 4, v36
    v_lshl_add_u32 v14, v6, 10, v36
    v_lshlrev_b32 v16, 4, v7
    v_lshl_add_u32 v16, v6, 10, v16
    v_lshl_add_u32 v16, v1, 7, v16
    v_lshrrev_b32 v36, 5, v2
    v_and_b32 v37, 31, v2
    v_and_b32 v38, 1, v3
    v_lshrrev_b32 v39, 2, v2
    v_and_b32 v39, 3, v39
    v_and_b32 v40, 3, v2
    v_lshrrev_b32 v41, 1, v40
    v_and_b32 v42, 1, v40
    v_lshlrev_b32 v43, 2, v39
    v_lshl_add_u32 v43, v38, 1, v43
    v_lshl_add_u32 v48, v36, 3, v39
    v_lshlrev_b32 v47, 7, v48
    v_lshl_add_u32 v47, v38, 5, v47
    v_lshl_add_u32 v47, v40, 3, v47
    v_lshlrev_b32 v48, 8, v48
    v_add_u32 v49, v43, v41
    v_lshl_add_u32 v48, v49, 4, v48
    v_lshl_add_u32 v48, v42, 3, v48
    v_lshlrev_b32 v49, 6, v50
    v_xor_b32 v17, v48, v49
    v_lshl_add_u32 v48, v36, 2, v39
    v_lshlrev_b32 v48, 8, v48
    v_add_u32 v52, v43, v42
    v_lshl_add_u32 v48, v52, 4, v48
    v_lshl_add_u32 v48, v41, 3, v48
    v_xor_b32 v30, v48, v49
    v_add_u32 v31, 65536, v30
    v_add_u32 v32, 131072, v30
    v_lshrrev_b32 v48, 1, v37
    v_and_b32 v48, 7, v48
    v_xor_b32 v48, v36, v48
    v_lshlrev_b32 v48, 4, v48
    v_lshl_add_u32 v48, v37, 7, v48
    v_lshl_add_u32 v48, v51, 12, v48
    v_xor_b32 v18, 0, v48
    v_xor_b32 v19, 32, v48
    v_xor_b32 v20, 64, v48
    v_xor_b32 v21, 96, v48
    v_and_b32 v48, 15, v37
    v_xor_b32 v48, v36, v48
    v_lshlrev_b32 v48, 4, v48
    v_lshl_add_u32 v48, v37, 8, v48
    v_xor_b32 v22, 0, v48
    v_xor_b32 v23, 32, v48
    v_xor_b32 v24, 64, v48
    v_xor_b32 v25, 96, v48
    v_xor_b32 v26, 128, v48
    v_xor_b32 v27, 160, v48
    v_xor_b32 v28, 192, v48
    v_xor_b32 v29, 224, v48
    v_and_b32 v48, 15, v37
    v_lshlrev_b32 v49, 2, v50
    v_xor_b32 v48, v48, v49
    v_lshlrev_b32 v48, 4, v48
    v_lshl_add_u32 v48, v37, 8, v48
    v_lshl_add_u32 v48, v51, 13, v48
    v_lshl_add_u32 v34, v36, 3, v48
    v_lshlrev_b32 v35, 4, v2
    v_mov_b32 v46, v37
    v_mov_b32 v45, v51
    s_waitcnt lgkmcnt(0)
    s_lshl_b32 s50, s46, 16
    s_add_u32 s4, s4, s50
    s_addc_u32 s5, s5, 0
    s_mov_b32 s20, s4
    s_mov_b32 s21, s5
    s_mov_b32 s22, 65536
    s_mov_b32 s23, 0x00020000
    s_lshl_b32 s50, s46, 20
    s_lshl_b32 s51, s44, 17
    s_add_u32 s50, s50, s51
    s_add_u32 s6, s6, s50
    s_addc_u32 s7, s7, 0
    s_mov_b32 s24, s6
    s_mov_b32 s25, s7
    s_mov_b32 s26, 131072
    s_mov_b32 s27, 0x00020000
    s_add_u32 s8, s8, s50
    s_addc_u32 s9, s9, 0
    s_mov_b32 s28, s8
    s_mov_b32 s29, s9
    s_mov_b32 s30, 131072
    s_mov_b32 s31, 0x00020000
    s_lshl_b32 s50, s48, 8
    s_add_u32 s10, s10, s50
    s_addc_u32 s11, s11, 0
    s_sub_u32 s51, 4194304, s50
    s_mov_b32 s32, s10
    s_mov_b32 s33, s11
    s_mov_b32 s34, s51
    s_mov_b32 s35, 0x00020000
    s_lshl_b32 s50, s2, 14
    s_add_u32 s12, s12, s50
    s_addc_u32 s13, s13, 0
    s_mov_b32 s36, s12
    s_mov_b32 s37, s13
    s_mov_b32 s38, 16384
    s_mov_b32 s39, 0x00020000
    s_mov_b32 s40, s18
    s_mov_b32 s41, s19
    s_mov_b32 s42, 8388608
    s_mov_b32 s43, 0x00020000
    s_lshl_b32 s52, s49, 10
    s_lshl_b32 s53, s49, 15
    s_lshl_b32 s54, s49, 11
    s_lshl_b32 s55, s49, 13
    s_lshl_b32 s56, s49, 14
    s_mov_b32 s57, 1040356334
    s_lshl_b32 s58, s47, 1
    s_add_u32 s58, s58, s46
    s_mov_b32 s68, 0
    s_mov_b32 s69, 8192
    s_add_u32 s59, s49, 18
    s_add_u32 s70, s49, 4
    s_cmp_lt_u32 s49, 2
    s_cselect_b32 s70, s59, s70
    s_lshl_b32 s70, s70, 13
    s_add_u32 s59, s49, 12
    s_sub_u32 s71, s49, 6
    s_cmp_lt_u32 s49, 6
    s_cselect_b32 s71, s59, s71
    s_lshl_b32 s71, s71, 13
    s_and_b32 s72, s47, 1
    s_lshl_b32 s72, s72, 13
    s_xor_b32 s73, s72, 8192
    s_add_u32 s72, s72, s52
    s_add_u32 s73, s73, s52
    s_add_u32 s59, s58, 0
    s_and_b32 s59, s59, 7
    s_lshl_b32 s74, s59, 19
    s_add_u32 s74, s74, s53
    s_lshl_b32 s75, s59, 7
    s_add_u32 s75, s75, s55
    s_add_u32 m0, s52, 0
    s_add_u32 s60, s74, 0
    buffer_load_dwordx4 v8, s[32:35], s60 offen lds
    s_add_u32 m0, s52, 8192
    s_add_u32 s61, s74, 262144
    buffer_load_dwordx4 v8, s[32:35], s61 offen lds
    s_add_u32 m0, s52, 16384
    s_nop 0
    buffer_load_dwordx4 v14, s[20:23], s75 offen lds
    s_add_u32 s59, s58, 1
    s_and_b32 s59, s59, 7
    s_lshl_b32 s74, s59, 19
    s_add_u32 s74, s74, s53
    s_lshl_b32 s75, s59, 7
    s_add_u32 s75, s75, s55
    s_add_u32 m0, s52, 24576
    s_add_u32 s62, s74, 0
    buffer_load_dwordx4 v8, s[32:35], s62 offen lds
    s_add_u32 m0, s52, 32768
    s_add_u32 s63, s74, 262144
    buffer_load_dwordx4 v8, s[32:35], s63 offen lds
    s_add_u32 m0, s52, 40960
    s_nop 0
    buffer_load_dwordx4 v14, s[20:23], s75 offen lds
    s_add_u32 s59, s58, 2
    s_and_b32 s59, s59, 7
    s_lshl_b32 s74, s59, 19
    s_add_u32 s74, s74, s53
    s_lshl_b32 s75, s59, 7
    s_add_u32 s75, s75, s55
    s_add_u32 m0, s52, 49152
    s_add_u32 s64, s74, 0
    buffer_load_dwordx4 v8, s[32:35], s64 offen lds
    s_add_u32 m0, s52, 57344
    s_add_u32 s65, s74, 262144
    buffer_load_dwordx4 v8, s[32:35], s65 offen lds
    s_add_u32 m0, s52, 65536
    s_nop 0
    buffer_load_dwordx4 v14, s[20:23], s75 offen lds
    s_add_u32 s59, s58, 3
    s_and_b32 s59, s59, 7
    s_lshl_b32 s74, s59, 19
    s_add_u32 s74, s74, s53
    s_lshl_b32 s75, s59, 7
    s_add_u32 s75, s75, s55
    s_add_u32 m0, s52, 73728
    s_add_u32 s66, s74, 0
    buffer_load_dwordx4 v8, s[32:35], s66 offen lds
    s_add_u32 m0, s52, 81920
    s_add_u32 s67, s74, 262144
    buffer_load_dwordx4 v8, s[32:35], s67 offen lds
    s_add_u32 m0, s52, 90112
    s_nop 0
    buffer_load_dwordx4 v14, s[20:23], s75 offen lds
    s_add_u32 s59, s58, 4
    s_and_b32 s59, s59, 7
    s_lshl_b32 s74, s59, 19
    s_add_u32 s74, s74, s53
    s_lshl_b32 s75, s59, 7
    s_add_u32 s75, s75, s55
    s_add_u32 m0, s52, 98304
    s_add_u32 s60, s74, 0
    buffer_load_dwordx4 v8, s[32:35], s60 offen lds
    s_add_u32 m0, s52, 106496
    s_add_u32 s61, s74, 262144
    buffer_load_dwordx4 v8, s[32:35], s61 offen lds
    s_add_u32 m0, s52, 114688
    s_nop 0
    buffer_load_dwordx4 v14, s[20:23], s75 offen lds
    s_add_u32 s59, s58, 5
    s_and_b32 s59, s59, 7
    s_lshl_b32 s74, s59, 19
    s_add_u32 s74, s74, s53
    s_lshl_b32 s75, s59, 7
    s_add_u32 s75, s75, s55
    s_add_u32 m0, s52, 122880
    s_add_u32 s62, s74, 0
    buffer_load_dwordx4 v8, s[32:35], s62 offen lds
    s_add_u32 m0, s52, 131072
    s_add_u32 s63, s74, 262144
    buffer_load_dwordx4 v8, s[32:35], s63 offen lds
    s_add_u32 m0, s52, 139264
    s_nop 0
    buffer_load_dwordx4 v14, s[20:23], s75 offen lds
    s_add_u32 m0, s52, 147456
    s_add_u32 s64, s72, 0
    buffer_load_dwordx4 v10, s[24:27], s64 offen lds
    s_add_u32 m0, s52, 155648
    s_add_u32 s65, s72, 16384
    buffer_load_dwordx4 v10, s[24:27], s65 offen lds
    s_waitcnt vmcnt(17)
    s_barrier
    v_add_u32 v36, 0, v17
    v_add_u32 v37, 16384, v18
    v_add_u32 v38, 16384, v19
    v_add_u32 v39, 16384, v20
    v_add_u32 v40, 16384, v21
    ds_read_b64_tr_b16 v[64:65], v36 offset:0
    ds_read_b64_tr_b16 v[66:67], v36 offset:1024
    ds_read_b128 v[80:83], v37
    ds_read_b64_tr_b16 v[68:69], v36 offset:4096
    ds_read_b64_tr_b16 v[70:71], v36 offset:5120
    ds_read_b128 v[84:87], v38
    ds_read_b64_tr_b16 v[72:73], v36 offset:8192
    ds_read_b64_tr_b16 v[74:75], v36 offset:9216
    ds_read_b128 v[88:91], v39
    ds_read_b64_tr_b16 v[76:77], v36 offset:12288
    ds_read_b64_tr_b16 v[78:79], v36 offset:13312
    ds_read_b128 v[92:95], v40
    s_waitcnt lgkmcnt(0)
    v_mfma_f32_32x32x16_bf16 a[0:15], v[64:67], v[80:83], 0
    s_waitcnt vmcnt(14)
    s_barrier
    v_add_u32 v36, 24576, v17
    v_add_u32 v37, 40960, v18
    v_add_u32 v38, 40960, v19
    v_add_u32 v39, 40960, v20
    v_add_u32 v40, 40960, v21
    ds_read_b64_tr_b16 v[96:97], v36 offset:0
    ds_read_b64_tr_b16 v[98:99], v36 offset:1024
    ds_read_b128 v[112:115], v37
    ds_read_b64_tr_b16 v[100:101], v36 offset:4096
    ds_read_b64_tr_b16 v[102:103], v36 offset:5120
    ds_read_b128 v[116:119], v38
    ds_read_b64_tr_b16 v[104:105], v36 offset:8192
    ds_read_b64_tr_b16 v[106:107], v36 offset:9216
    ds_read_b128 v[120:123], v39
    ds_read_b64_tr_b16 v[108:109], v36 offset:12288
    ds_read_b64_tr_b16 v[110:111], v36 offset:13312
    ds_read_b128 v[124:127], v40
    v_mfma_f32_32x32x16_bf16 a[0:15], v[68:71], v[84:87], a[0:15]
    s_add_u32 s59, s58, 6
    s_and_b32 s59, s59, 7
    s_lshl_b32 s74, s59, 19
    s_add_u32 s74, s74, s53
    s_lshl_b32 s75, s59, 7
    s_add_u32 s75, s75, s55
    s_add_u32 m0, s52, 0
    s_add_u32 s66, s74, 0
    buffer_load_dwordx4 v8, s[32:35], s66 offen lds
    s_add_u32 m0, s52, 8192
    s_add_u32 s67, s74, 262144
    buffer_load_dwordx4 v8, s[32:35], s67 offen lds
    v_mfma_f32_32x32x16_bf16 a[0:15], v[72:75], v[88:91], a[0:15]
    s_add_u32 m0, s52, 16384
    s_nop 0
    buffer_load_dwordx4 v14, s[20:23], s75 offen lds
    buffer_load_dwordx4 v[56:59], v16, s[36:39], s68 offen
    v_mfma_f32_32x32x16_bf16 a[0:15], v[76:79], v[92:95], a[0:15]
    buffer_load_dwordx4 v[60:63], v16, s[36:39], s69 offen
    s_waitcnt lgkmcnt(0)
    v_mfma_f32_32x32x16_bf16 a[0:15], v[96:99], v[112:115], a[0:15]
    s_waitcnt vmcnt(16)
    s_barrier
    v_add_u32 v36, 49152, v17
    v_add_u32 v37, 65536, v18
    v_add_u32 v38, 65536, v19
    v_add_u32 v39, 65536, v20
    v_add_u32 v40, 65536, v21
    ds_read_b64_tr_b16 v[64:65], v36 offset:0
    ds_read_b64_tr_b16 v[66:67], v36 offset:1024
    ds_read_b128 v[80:83], v37
    ds_read_b64_tr_b16 v[68:69], v36 offset:4096
    ds_read_b64_tr_b16 v[70:71], v36 offset:5120
    ds_read_b128 v[84:87], v38
    ds_read_b64_tr_b16 v[72:73], v36 offset:8192
    ds_read_b64_tr_b16 v[74:75], v36 offset:9216
    ds_read_b128 v[88:91], v39
    ds_read_b64_tr_b16 v[76:77], v36 offset:12288
    ds_read_b64_tr_b16 v[78:79], v36 offset:13312
    ds_read_b128 v[92:95], v40
    v_mfma_f32_32x32x16_bf16 a[0:15], v[100:103], v[116:119], a[0:15]
    s_add_u32 s59, s58, 7
    s_and_b32 s59, s59, 7
    s_lshl_b32 s74, s59, 19
    s_add_u32 s74, s74, s53
    s_lshl_b32 s75, s59, 7
    s_add_u32 s75, s75, s55
    s_add_u32 m0, s52, 24576
    s_add_u32 s60, s74, 0
    buffer_load_dwordx4 v8, s[32:35], s60 offen lds
    s_add_u32 m0, s52, 32768
    s_add_u32 s61, s74, 262144
    buffer_load_dwordx4 v8, s[32:35], s61 offen lds
    v_mfma_f32_32x32x16_bf16 a[0:15], v[104:107], v[120:123], a[0:15]
    s_add_u32 m0, s52, 40960
    s_nop 0
    buffer_load_dwordx4 v14, s[20:23], s75 offen lds
    v_mfma_f32_32x32x16_bf16 a[0:15], v[108:111], v[124:127], a[0:15]
    s_waitcnt lgkmcnt(0)
    v_mfma_f32_32x32x16_bf16 a[0:15], v[64:67], v[80:83], a[0:15]
    s_waitcnt vmcnt(16)
    s_barrier
    v_add_u32 v36, 73728, v17
    v_add_u32 v37, 90112, v18
    v_add_u32 v38, 90112, v19
    v_add_u32 v39, 90112, v20
    v_add_u32 v40, 90112, v21
    ds_read_b64_tr_b16 v[96:97], v36 offset:0
    ds_read_b64_tr_b16 v[98:99], v36 offset:1024
    ds_read_b128 v[112:115], v37
    ds_read_b64_tr_b16 v[100:101], v36 offset:4096
    ds_read_b64_tr_b16 v[102:103], v36 offset:5120
    ds_read_b128 v[116:119], v38
    ds_read_b64_tr_b16 v[104:105], v36 offset:8192
    ds_read_b64_tr_b16 v[106:107], v36 offset:9216
    ds_read_b128 v[120:123], v39
    ds_read_b64_tr_b16 v[108:109], v36 offset:12288
    ds_read_b64_tr_b16 v[110:111], v36 offset:13312
    ds_read_b128 v[124:127], v40
    v_mfma_f32_32x32x16_bf16 a[0:15], v[68:71], v[84:87], a[0:15]
    s_add_u32 m0, s52, 49152
    s_add_u32 s62, s72, 32768
    buffer_load_dwordx4 v10, s[24:27], s62 offen lds
    s_add_u32 m0, s52, 57344
    s_add_u32 s63, s72, 49152
    buffer_load_dwordx4 v10, s[24:27], s63 offen lds
    v_mfma_f32_32x32x16_bf16 a[0:15], v[72:75], v[88:91], a[0:15]
    s_add_u32 m0, s52, 65536
    s_add_u32 s64, s72, 65536
    buffer_load_dwordx4 v10, s[24:27], s64 offen lds
    v_mfma_f32_32x32x16_bf16 a[0:15], v[76:79], v[92:95], a[0:15]
    s_waitcnt lgkmcnt(0)
    v_mfma_f32_32x32x16_bf16 a[0:15], v[96:99], v[112:115], a[0:15]
    s_waitcnt vmcnt(16)
    s_barrier
    v_add_u32 v36, 98304, v17
    v_add_u32 v37, 114688, v18
    v_add_u32 v38, 114688, v19
    v_add_u32 v39, 114688, v20
    v_add_u32 v40, 114688, v21
    ds_read_b64_tr_b16 v[64:65], v36 offset:0
    ds_read_b64_tr_b16 v[66:67], v36 offset:1024
    ds_read_b128 v[80:83], v37
    ds_read_b64_tr_b16 v[68:69], v36 offset:4096
    ds_read_b64_tr_b16 v[70:71], v36 offset:5120
    ds_read_b128 v[84:87], v38
    ds_read_b64_tr_b16 v[72:73], v36 offset:8192
    ds_read_b64_tr_b16 v[74:75], v36 offset:9216
    ds_read_b128 v[88:91], v39
    ds_read_b64_tr_b16 v[76:77], v36 offset:12288
    ds_read_b64_tr_b16 v[78:79], v36 offset:13312
    ds_read_b128 v[92:95], v40
    v_mfma_f32_32x32x16_bf16 a[0:15], v[100:103], v[116:119], a[0:15]
    s_add_u32 m0, s52, 73728
    s_add_u32 s65, s72, 81920
    buffer_load_dwordx4 v10, s[24:27], s65 offen lds
    s_add_u32 m0, s52, 81920
    s_add_u32 s66, s72, 98304
    buffer_load_dwordx4 v10, s[24:27], s66 offen lds
    v_mfma_f32_32x32x16_bf16 a[0:15], v[104:107], v[120:123], a[0:15]
    s_add_u32 m0, s52, 90112
    s_add_u32 s67, s72, 114688
    buffer_load_dwordx4 v10, s[24:27], s67 offen lds
    v_mfma_f32_32x32x16_bf16 a[0:15], v[108:111], v[124:127], a[0:15]
    s_waitcnt lgkmcnt(0)
    v_mfma_f32_32x32x16_bf16 a[0:15], v[64:67], v[80:83], a[0:15]
    s_waitcnt vmcnt(16)
    s_barrier
    v_add_u32 v36, 122880, v17
    v_add_u32 v37, 139264, v18
    v_add_u32 v38, 139264, v19
    v_add_u32 v39, 139264, v20
    v_add_u32 v40, 139264, v21
    ds_read_b64_tr_b16 v[96:97], v36 offset:0
    ds_read_b64_tr_b16 v[98:99], v36 offset:1024
    ds_read_b128 v[112:115], v37
    ds_read_b64_tr_b16 v[100:101], v36 offset:4096
    ds_read_b64_tr_b16 v[102:103], v36 offset:5120
    ds_read_b128 v[116:119], v38
    ds_read_b64_tr_b16 v[104:105], v36 offset:8192
    ds_read_b64_tr_b16 v[106:107], v36 offset:9216
    ds_read_b128 v[120:123], v39
    ds_read_b64_tr_b16 v[108:109], v36 offset:12288
    ds_read_b64_tr_b16 v[110:111], v36 offset:13312
    ds_read_b128 v[124:127], v40
    v_mfma_f32_32x32x16_bf16 a[0:15], v[68:71], v[84:87], a[0:15]
    s_add_u32 m0, s52, 98304
    s_add_u32 s60, s73, 0
    buffer_load_dwordx4 v10, s[24:27], s60 offen lds
    s_add_u32 m0, s52, 106496
    s_add_u32 s61, s73, 16384
    buffer_load_dwordx4 v10, s[24:27], s61 offen lds
    v_mfma_f32_32x32x16_bf16 a[0:15], v[72:75], v[88:91], a[0:15]
    s_add_u32 m0, s52, 114688
    s_add_u32 s62, s73, 32768
    buffer_load_dwordx4 v10, s[24:27], s62 offen lds
    v_mfma_f32_32x32x16_bf16 a[0:15], v[76:79], v[92:95], a[0:15]
    s_waitcnt lgkmcnt(0)
    v_mfma_f32_32x32x16_bf16 a[0:15], v[96:99], v[112:115], a[0:15]
    s_waitcnt vmcnt(14)
    s_barrier
    v_add_u32 v36, 0, v17
    v_add_u32 v37, 16384, v18
    v_add_u32 v38, 16384, v19
    v_add_u32 v39, 16384, v20
    v_add_u32 v40, 16384, v21
    ds_read_b64_tr_b16 v[64:65], v36 offset:0
    ds_read_b64_tr_b16 v[66:67], v36 offset:1024
    ds_read_b128 v[80:83], v37
    ds_read_b64_tr_b16 v[68:69], v36 offset:4096
    ds_read_b64_tr_b16 v[70:71], v36 offset:5120
    ds_read_b128 v[84:87], v38
    ds_read_b64_tr_b16 v[72:73], v36 offset:8192
    ds_read_b64_tr_b16 v[74:75], v36 offset:9216
    ds_read_b128 v[88:91], v39
    ds_read_b64_tr_b16 v[76:77], v36 offset:12288
    ds_read_b64_tr_b16 v[78:79], v36 offset:13312
    ds_read_b128 v[92:95], v40
    v_mfma_f32_32x32x16_bf16 a[0:15], v[100:103], v[116:119], a[0:15]
    s_add_u32 m0, s52, 122880
    s_add_u32 s63, s73, 49152
    buffer_load_dwordx4 v10, s[24:27], s63 offen lds
    s_add_u32 m0, s52, 131072
    s_add_u32 s64, s73, 65536
    buffer_load_dwordx4 v10, s[24:27], s64 offen lds
    v_mfma_f32_32x32x16_bf16 a[0:15], v[104:107], v[120:123], a[0:15]
    s_add_u32 m0, s52, 139264
    s_add_u32 s65, s73, 81920
    buffer_load_dwordx4 v10, s[24:27], s65 offen lds
    v_mfma_f32_32x32x16_bf16 a[0:15], v[108:111], v[124:127], a[0:15]
    s_waitcnt lgkmcnt(0)
    v_mfma_f32_32x32x16_bf16 a[0:15], v[64:67], v[80:83], a[0:15]
    s_waitcnt vmcnt(12)
    s_barrier
    v_add_u32 v36, 24576, v17
    v_add_u32 v37, 40960, v18
    v_add_u32 v38, 40960, v19
    v_add_u32 v39, 40960, v20
    v_add_u32 v40, 40960, v21
    ds_read_b64_tr_b16 v[96:97], v36 offset:0
    ds_read_b64_tr_b16 v[98:99], v36 offset:1024
    ds_read_b128 v[112:115], v37
    ds_read_b64_tr_b16 v[100:101], v36 offset:4096
    ds_read_b64_tr_b16 v[102:103], v36 offset:5120
    ds_read_b128 v[116:119], v38
    ds_read_b64_tr_b16 v[104:105], v36 offset:8192
    ds_read_b64_tr_b16 v[106:107], v36 offset:9216
    ds_read_b128 v[120:123], v39
    ds_read_b64_tr_b16 v[108:109], v36 offset:12288
    ds_read_b64_tr_b16 v[110:111], v36 offset:13312
    ds_read_b128 v[124:127], v40
    v_mfma_f32_32x32x16_bf16 a[0:15], v[68:71], v[84:87], a[0:15]
    s_add_u32 m0, s52, 0
    s_add_u32 s66, s73, 98304
    buffer_load_dwordx4 v10, s[24:27], s66 offen lds
    s_add_u32 m0, s52, 8192
    s_add_u32 s67, s73, 114688
    buffer_load_dwordx4 v10, s[24:27], s67 offen lds
    v_mfma_f32_32x32x16_bf16 a[0:15], v[72:75], v[88:91], a[0:15]
    v_mfma_f32_32x32x16_bf16 a[0:15], v[76:79], v[92:95], a[0:15]
    s_waitcnt lgkmcnt(0)
    v_mfma_f32_32x32x16_bf16 a[0:15], v[96:99], v[112:115], a[0:15]
    s_barrier
    v_mfma_f32_32x32x16_bf16 a[0:15], v[100:103], v[116:119], a[0:15]
    v_mfma_f32_32x32x16_bf16 a[0:15], v[104:107], v[120:123], a[0:15]
    v_mfma_f32_32x32x16_bf16 a[0:15], v[108:111], v[124:127], a[0:15]
    s_nop 11
    v_accvgpr_read_b32 v64, a0
    v_accvgpr_read_b32 v65, a1
    v_accvgpr_read_b32 v66, a2
    v_accvgpr_read_b32 v67, a3
    v_cvt_pk_bf16_f32 v68, v64, v65
    v_cvt_pk_bf16_f32 v69, v66, v67
    v_xor_b32 v70, 0, v34
    v_add_u32 v70, 16384, v70
    ds_write_b64 v70, v[68:69]
    v_accvgpr_read_b32 v72, a4
    v_accvgpr_read_b32 v73, a5
    v_accvgpr_read_b32 v74, a6
    v_accvgpr_read_b32 v75, a7
    v_cvt_pk_bf16_f32 v76, v72, v73
    v_cvt_pk_bf16_f32 v77, v74, v75
    v_xor_b32 v78, 16, v34
    v_add_u32 v78, 16384, v78
    ds_write_b64 v78, v[76:77]
    v_accvgpr_read_b32 v80, a8
    v_accvgpr_read_b32 v81, a9
    v_accvgpr_read_b32 v82, a10
    v_accvgpr_read_b32 v83, a11
    v_cvt_pk_bf16_f32 v84, v80, v81
    v_cvt_pk_bf16_f32 v85, v82, v83
    v_xor_b32 v86, 32, v34
    v_add_u32 v86, 16384, v86
    ds_write_b64 v86, v[84:85]
    v_accvgpr_read_b32 v88, a12
    v_accvgpr_read_b32 v89, a13
    v_accvgpr_read_b32 v90, a14
    v_accvgpr_read_b32 v91, a15
    v_cvt_pk_bf16_f32 v92, v88, v89
    v_cvt_pk_bf16_f32 v93, v90, v91
    v_xor_b32 v94, 48, v34
    v_add_u32 v94, 16384, v94
    ds_write_b64 v94, v[92:93]
    v_add_u32 v36, 16384, v22
    v_add_u32 v37, 16384, v23
    v_add_u32 v38, 16384, v24
    v_add_u32 v39, 16384, v25
    v_add_u32 v40, 16384, v26
    v_add_u32 v41, 16384, v27
    v_add_u32 v42, 16384, v28
    v_add_u32 v43, 16384, v29
    s_waitcnt vmcnt(8) lgkmcnt(0)
    s_barrier
    ds_read_b128 a[16:19], v36 offset:0
    ds_read_b128 a[20:23], v37 offset:0
    ds_read_b128 a[24:27], v38 offset:0
    ds_read_b128 a[28:31], v39 offset:0
    ds_read_b128 a[32:35], v40 offset:0
    ds_read_b128 a[36:39], v41 offset:0
    ds_read_b128 a[40:43], v42 offset:0
    ds_read_b128 a[44:47], v43 offset:0
    s_waitcnt lgkmcnt(0)
    ds_read_b128 a[48:51], v36 offset:8192
    ds_read_b128 a[52:55], v37 offset:8192
    ds_read_b128 a[56:59], v38 offset:8192
    ds_read_b128 a[60:63], v39 offset:8192
    ds_read_b128 a[64:67], v40 offset:8192
    ds_read_b128 a[68:71], v41 offset:8192
    ds_read_b128 a[72:75], v42 offset:8192
    ds_read_b128 a[76:79], v43 offset:8192
    s_waitcnt lgkmcnt(0)
    v_add_u32 v36, s70, v22
    v_add_u32 v37, s70, v23
    v_add_u32 v38, s70, v24
    v_add_u32 v39, s70, v25
    v_add_u32 v40, s70, v26
    v_add_u32 v41, s70, v27
    v_add_u32 v42, s70, v28
    v_add_u32 v43, s70, v29
    ds_read_b128 v[96:99], v36
    ds_read_b128 v[100:103], v37
    ds_read_b128 v[104:107], v38
    ds_read_b128 v[108:111], v39
    ds_read_b128 v[112:115], v40
    ds_read_b128 v[116:119], v41
    ds_read_b128 v[120:123], v42
    ds_read_b128 v[124:127], v43
    s_waitcnt lgkmcnt(0)
    v_mfma_f32_32x32x16_bf16 v[64:79], v[96:99], a[16:19], 0
    v_mfma_f32_32x32x16_bf16 v[80:95], v[96:99], a[48:51], 0
    s_sub_u32 s76, s72, s52
    s_add_u32 s76, s76, s56
    s_add_u32 m0, s70, 0
    s_nop 0
    buffer_load_dwordx4 v9, s[28:31], s76 offen lds
    v_mfma_f32_32x32x16_bf16 v[64:79], v[100:103], a[20:23], v[64:79]
    v_mfma_f32_32x32x16_bf16 v[80:95], v[100:103], a[52:55], v[80:95]
    v_mfma_f32_32x32x16_bf16 v[64:79], v[104:107], a[24:27], v[64:79]
    v_mfma_f32_32x32x16_bf16 v[80:95], v[104:107], a[56:59], v[80:95]
    s_add_u32 m0, s70, 0
    s_nop 0
    buffer_load_dwordx4 v9, s[28:31], s76 offen offset:1024 lds
    v_mfma_f32_32x32x16_bf16 v[64:79], v[108:111], a[28:31], v[64:79]
    v_mfma_f32_32x32x16_bf16 v[80:95], v[108:111], a[60:63], v[80:95]
    s_waitcnt vmcnt(2)
    s_barrier
    v_add_u32 v36, s71, v22
    v_add_u32 v37, s71, v23
    v_add_u32 v38, s71, v24
    v_add_u32 v39, s71, v25
    v_add_u32 v40, s71, v26
    v_add_u32 v41, s71, v27
    v_add_u32 v42, s71, v28
    v_add_u32 v43, s71, v29
    ds_read_b128 a[80:83], v36
    ds_read_b128 a[84:87], v37
    ds_read_b128 a[88:91], v38
    ds_read_b128 a[92:95], v39
    ds_read_b128 a[96:99], v40
    ds_read_b128 a[100:103], v41
    ds_read_b128 a[104:107], v42
    ds_read_b128 a[108:111], v43
    v_mfma_f32_32x32x16_bf16 v[64:79], v[112:115], a[32:35], v[64:79]
    v_mfma_f32_32x32x16_bf16 v[80:95], v[112:115], a[64:67], v[80:95]
    s_add_u32 m0, s70, 0
    s_nop 0
    buffer_load_dwordx4 v9, s[28:31], s76 offen offset:2048 lds
    v_mfma_f32_32x32x16_bf16 v[64:79], v[116:119], a[36:39], v[64:79]
    v_mfma_f32_32x32x16_bf16 v[80:95], v[116:119], a[68:71], v[80:95]
    v_mfma_f32_32x32x16_bf16 v[64:79], v[120:123], a[40:43], v[64:79]
    v_mfma_f32_32x32x16_bf16 v[80:95], v[120:123], a[72:75], v[80:95]
    s_add_u32 m0, s70, 0
    s_nop 0
    buffer_load_dwordx4 v9, s[28:31], s76 offen offset:3072 lds
    v_mfma_f32_32x32x16_bf16 v[64:79], v[124:127], a[44:47], v[64:79]
    v_mfma_f32_32x32x16_bf16 v[80:95], v[124:127], a[76:79], v[80:95]
    s_waitcnt lgkmcnt(0)
    v_mfma_f32_32x32x16_bf16 v[96:111], a[80:83], a[16:19], 0
    v_mfma_f32_32x32x16_bf16 v[112:127], a[80:83], a[48:51], 0
    s_sub_u32 s76, s72, s52
    s_add_u32 s76, s76, s56
    s_add_u32 s76, s76, 4096
    s_add_u32 m0, s70, 4096
    s_nop 0
    buffer_load_dwordx4 v9, s[28:31], s76 offen lds
    v_mfma_f32_32x32x16_bf16 v[96:111], a[84:87], a[20:23], v[96:111]
    v_mfma_f32_32x32x16_bf16 v[112:127], a[84:87], a[52:55], v[112:127]
    v_mfma_f32_32x32x16_bf16 v[96:111], a[88:91], a[24:27], v[96:111]
    v_mfma_f32_32x32x16_bf16 v[112:127], a[88:91], a[56:59], v[112:127]
    s_add_u32 m0, s70, 4096
    s_nop 0
    buffer_load_dwordx4 v9, s[28:31], s76 offen offset:1024 lds
    v_mfma_f32_32x32x16_bf16 v[96:111], a[92:95], a[28:31], v[96:111]
    v_mfma_f32_32x32x16_bf16 v[112:127], a[92:95], a[60:63], v[112:127]
    v_mfma_f32_32x32x16_bf16 v[96:111], a[96:99], a[32:35], v[96:111]
    v_mfma_f32_32x32x16_bf16 v[112:127], a[96:99], a[64:67], v[112:127]
    s_add_u32 m0, s70, 4096
    s_nop 0
    buffer_load_dwordx4 v9, s[28:31], s76 offen offset:2048 lds
    v_mfma_f32_32x32x16_bf16 v[96:111], a[100:103], a[36:39], v[96:111]
    v_mfma_f32_32x32x16_bf16 v[112:127], a[100:103], a[68:71], v[112:127]
    v_mfma_f32_32x32x16_bf16 v[96:111], a[104:107], a[40:43], v[96:111]
    v_mfma_f32_32x32x16_bf16 v[112:127], a[104:107], a[72:75], v[112:127]
    s_add_u32 m0, s70, 4096
    s_nop 0
    buffer_load_dwordx4 v9, s[28:31], s76 offen offset:3072 lds
    v_mfma_f32_32x32x16_bf16 v[96:111], a[108:111], a[44:47], v[96:111]
    v_mfma_f32_32x32x16_bf16 v[112:127], a[108:111], a[76:79], v[112:127]
    v_max3_f32 v48, v64, v65, v66
    s_nop 9
    v_max3_f32 v49, v96, v97, v98
    v_max3_f32 v50, v80, v81, v82
    v_max3_f32 v51, v112, v113, v114
    v_max3_f32 v48, v48, v67, v68
    v_max3_f32 v49, v49, v99, v100
    v_max3_f32 v50, v50, v83, v84
    v_max3_f32 v51, v51, v115, v116
    s_sub_u32 s76, s73, s52
    s_add_u32 s76, s76, s56
    s_add_u32 m0, s71, 0
    s_nop 0
    buffer_load_dwordx4 v9, s[28:31], s76 offen lds
    v_max3_f32 v48, v48, v69, v70
    v_max3_f32 v49, v49, v101, v102
    v_max3_f32 v50, v50, v85, v86
    v_max3_f32 v51, v51, v117, v118
    v_max3_f32 v48, v48, v71, v72
    v_max3_f32 v49, v49, v103, v104
    v_max3_f32 v50, v50, v87, v88
    v_max3_f32 v51, v51, v119, v120
    v_max3_f32 v48, v48, v73, v74
    v_max3_f32 v49, v49, v105, v106
    v_max3_f32 v50, v50, v89, v90
    v_max3_f32 v51, v51, v121, v122
    v_max3_f32 v48, v48, v75, v76
    v_max3_f32 v49, v49, v107, v108
    v_max3_f32 v50, v50, v91, v92
    v_max3_f32 v51, v51, v123, v124
    s_add_u32 m0, s71, 0
    s_nop 0
    buffer_load_dwordx4 v9, s[28:31], s76 offen offset:1024 lds
    v_max3_f32 v48, v48, v77, v78
    v_max3_f32 v49, v49, v109, v110
    v_max3_f32 v50, v50, v93, v94
    v_max3_f32 v51, v51, v125, v126
    v_max3_f32 v48, v48, v79, v111
    v_max_f32 v48, v48, v49
    v_max3_f32 v50, v50, v95, v127
    v_max_f32 v50, v50, v51
    v_mov_b32 v49, v48
    v_mov_b32 v51, v50
    v_lshlrev_b32 v36, 5, v46
    v_add_u32 v36, 32768, v36
    v_lshl_add_u32 v37, v1, 2, v36
    v_permlane32_swap_b32 v48, v49
    v_permlane32_swap_b32 v50, v51
    v_max_f32 v48, v48, v49
    v_max_f32 v50, v50, v51
    ds_write_b32 v37, v48 offset:0
    ds_write_b32 v37, v50 offset:1024
    v_add_u32 v38, s54, v35
    v_add_u32 v38, 16384, v38
    s_waitcnt lgkmcnt(0)
    s_barrier
    ds_read_b128 v[128:131], v36 offset:0
    ds_read_b128 v[132:135], v36 offset:16
    ds_read_b128 v[136:139], v36 offset:1024
    ds_read_b128 v[140:143], v36 offset:1040
    ds_write_b128 v38, v[56:59] offset:0
    ds_write_b128 v38, v[60:63] offset:1024
    v_add_u32 v39, s54, v47
    v_add_u32 v39, 16384, v39
    s_lshl_b32 s58, s49, 19
    s_lshl_b32 s59, s2, 10
    s_add_u32 s58, s58, s59
    v_mov_b32 v50, 0
    v_mov_b32 v51, 0
    v_mov_b32 v52, 0
    v_mov_b32 v53, 0
    v_lshl_add_u32 v42, v45, 10, v35
    v_add_u32 v42, 16384, v42
    s_waitcnt lgkmcnt(2)
    v_max3_f32 v128, v128, v129, v130
    v_max3_f32 v131, v131, v132, v133
    v_max3_f32 v128, v128, v134, v135
    v_max_f32 v128, v128, v131
    v_mul_f32 v48, s57, v128
    v_max3_f32 v136, v136, v137, v138
    v_max3_f32 v139, v139, v140, v141
    v_max3_f32 v136, v136, v142, v143
    v_max_f32 v136, v136, v139
    v_mul_f32 v49, s57, v136
    s_add_u32 m0, s71, 0
    s_nop 0
    buffer_load_dwordx4 v9, s[28:31], s76 offen offset:2048 lds
    v_fma_f32 v64, v64, s57, -v48
    v_fma_f32 v65, v65, s57, -v48
    v_fma_f32 v66, v66, s57, -v48
    v_fma_f32 v67, v67, s57, -v48
    v_fma_f32 v68, v68, s57, -v48
    v_fma_f32 v69, v69, s57, -v48
    v_fma_f32 v70, v70, s57, -v48
    v_fma_f32 v71, v71, s57, -v48
    v_fma_f32 v80, v80, s57, -v49
    v_fma_f32 v81, v81, s57, -v49
    v_fma_f32 v82, v82, s57, -v49
    v_fma_f32 v83, v83, s57, -v49
    v_fma_f32 v84, v84, s57, -v49
    v_fma_f32 v85, v85, s57, -v49
    v_fma_f32 v86, v86, s57, -v49
    v_fma_f32 v87, v87, s57, -v49
    s_add_u32 m0, s71, 0
    s_nop 0
    buffer_load_dwordx4 v9, s[28:31], s76 offen offset:3072 lds
    s_waitcnt lgkmcnt(0)
    ds_read_b64_tr_b16 v[56:57], v39 offset:0
    ds_read_b64_tr_b16 v[58:59], v39 offset:512
    ds_read_b64_tr_b16 v[60:61], v39 offset:64
    ds_read_b64_tr_b16 v[62:63], v39 offset:576
    v_exp_f32 v64, v64
    v_exp_f32 v65, v65
    v_exp_f32 v66, v66
    v_exp_f32 v67, v67
    v_exp_f32 v68, v68
    v_exp_f32 v69, v69
    v_exp_f32 v70, v70
    v_exp_f32 v71, v71
    v_exp_f32 v80, v80
    v_exp_f32 v81, v81
    v_exp_f32 v82, v82
    v_exp_f32 v83, v83
    v_exp_f32 v84, v84
    v_exp_f32 v85, v85
    v_exp_f32 v86, v86
    v_exp_f32 v87, v87
    v_add_f32 v50, v50, v64
    v_add_f32 v51, v51, v65
    v_add_f32 v50, v50, v66
    v_add_f32 v51, v51, v67
    s_sub_u32 s76, s73, s52
    s_add_u32 s76, s76, s56
    s_add_u32 s76, s76, 4096
    s_add_u32 m0, s71, 4096
    s_nop 0
    buffer_load_dwordx4 v9, s[28:31], s76 offen lds
    v_add_f32 v50, v50, v68
    v_add_f32 v51, v51, v69
    v_add_f32 v50, v50, v70
    v_add_f32 v51, v51, v71
    v_cvt_pk_bf16_f32 v64, v64, v65
    v_cvt_pk_bf16_f32 v65, v66, v67
    v_cvt_pk_bf16_f32 v66, v68, v69
    v_cvt_pk_bf16_f32 v67, v70, v71
    v_add_f32 v52, v52, v80
    v_add_f32 v53, v53, v81
    v_add_f32 v52, v52, v82
    v_add_f32 v53, v53, v83
    v_add_f32 v52, v52, v84
    v_add_f32 v53, v53, v85
    v_add_f32 v52, v52, v86
    v_add_f32 v53, v53, v87
    v_cvt_pk_bf16_f32 v80, v80, v81
    v_cvt_pk_bf16_f32 v81, v82, v83
    v_cvt_pk_bf16_f32 v82, v84, v85
    v_cvt_pk_bf16_f32 v83, v86, v87
    s_waitcnt lgkmcnt(0)
    ds_write_b128 v38, v[64:67] offset:0
    ds_write_b128 v38, v[80:83] offset:1024
    s_add_u32 s68, s58, 4194304
    buffer_store_dwordx4 v[56:59], v35, s[40:43], s68 offen sc0 sc1
    s_add_u32 s69, s58, 4456448
    buffer_store_dwordx4 v[60:63], v35, s[40:43], s69 offen sc0 sc1
    s_waitcnt vmcnt(7) lgkmcnt(0)
    s_barrier
    ds_read_b64_tr_b16 a[16:17], v32 offset:16384
    ds_read_b64_tr_b16 a[18:19], v32 offset:18432
    ds_read_b128 a[20:23], v42 offset:0
    ds_read_b64_tr_b16 a[24:25], v32 offset:24576
    ds_read_b64_tr_b16 a[26:27], v32 offset:26624
    ds_read_b128 a[28:31], v42 offset:2048
    ds_read_b64_tr_b16 a[32:33], v30 offset:49152
    ds_read_b64_tr_b16 a[34:35], v30 offset:51200
    ds_read_b128 a[36:39], v42 offset:4096
    ds_read_b64_tr_b16 a[40:41], v30 offset:57344
    ds_read_b64_tr_b16 a[42:43], v30 offset:59392
    ds_read_b128 a[44:47], v42 offset:6144
    v_fma_f32 v72, v72, s57, -v48
    v_fma_f32 v73, v73, s57, -v48
    v_fma_f32 v74, v74, s57, -v48
    v_fma_f32 v75, v75, s57, -v48
    v_fma_f32 v76, v76, s57, -v48
    v_fma_f32 v77, v77, s57, -v48
    v_fma_f32 v78, v78, s57, -v48
    v_fma_f32 v79, v79, s57, -v48
    v_fma_f32 v88, v88, s57, -v49
    v_fma_f32 v89, v89, s57, -v49
    v_fma_f32 v90, v90, s57, -v49
    v_fma_f32 v91, v91, s57, -v49
    v_fma_f32 v92, v92, s57, -v49
    v_fma_f32 v93, v93, s57, -v49
    v_fma_f32 v94, v94, s57, -v49
    v_fma_f32 v95, v95, s57, -v49
    v_exp_f32 v72, v72
    v_exp_f32 v73, v73
    v_exp_f32 v74, v74
    v_exp_f32 v75, v75
    s_waitcnt lgkmcnt(9)
    ds_read_b64_tr_b16 a[48:49], v31 offset:0
    ds_read_b64_tr_b16 a[50:51], v31 offset:2048
    ds_read_b128 a[52:55], v42 offset:8192
    v_mfma_f32_32x32x16_bf16 a[0:15], a[16:19], a[20:23], 0
    s_add_u32 m0, s71, 4096
    s_nop 0
    buffer_load_dwordx4 v9, s[28:31], s76 offen offset:1024 lds
    v_exp_f32 v76, v76
    v_exp_f32 v77, v77
    v_exp_f32 v78, v78
    v_exp_f32 v79, v79
    v_exp_f32 v88, v88
    v_exp_f32 v89, v89
    s_waitcnt lgkmcnt(9)
    ds_read_b64_tr_b16 a[56:57], v31 offset:8192
    ds_read_b64_tr_b16 a[58:59], v31 offset:10240
    ds_read_b128 a[60:63], v42 offset:10240
    v_mfma_f32_32x32x16_bf16 a[0:15], a[24:27], a[28:31], a[0:15]
    v_exp_f32 v90, v90
    v_exp_f32 v91, v91
    v_exp_f32 v92, v92
    v_exp_f32 v93, v93
    v_exp_f32 v94, v94
    v_exp_f32 v95, v95
    s_waitcnt lgkmcnt(9)
    ds_read_b64_tr_b16 a[64:65], v31 offset:16384
    ds_read_b64_tr_b16 a[66:67], v31 offset:18432
    ds_read_b128 a[68:71], v42 offset:12288
    v_mfma_f32_32x32x16_bf16 a[0:15], a[32:35], a[36:39], a[0:15]
    v_add_f32 v50, v50, v72
    v_add_f32 v51, v51, v73
    v_add_f32 v50, v50, v74
    v_add_f32 v51, v51, v75
    v_add_f32 v50, v50, v76
    v_add_f32 v51, v51, v77
    s_waitcnt lgkmcnt(9)
    ds_read_b64_tr_b16 a[72:73], v31 offset:24576
    ds_read_b64_tr_b16 a[74:75], v31 offset:26624
    ds_read_b128 a[76:79], v42 offset:14336
    v_mfma_f32_32x32x16_bf16 a[0:15], a[40:43], a[44:47], a[0:15]
    s_add_u32 m0, s71, 4096
    s_nop 0
    buffer_load_dwordx4 v9, s[28:31], s76 offen offset:2048 lds
    v_add_f32 v50, v50, v78
    v_add_f32 v51, v51, v79
    v_cvt_pk_bf16_f32 v72, v72, v73
    v_cvt_pk_bf16_f32 v73, v74, v75
    v_cvt_pk_bf16_f32 v74, v76, v77
    v_cvt_pk_bf16_f32 v75, v78, v79
    s_waitcnt lgkmcnt(9)
    v_mfma_f32_32x32x16_bf16 a[0:15], a[48:51], a[52:55], a[0:15]
    v_add_f32 v52, v52, v88
    v_add_f32 v53, v53, v89
    v_add_f32 v52, v52, v90
    v_add_f32 v53, v53, v91
    v_add_f32 v52, v52, v92
    v_add_f32 v53, v53, v93
    s_waitcnt lgkmcnt(6)
    v_mfma_f32_32x32x16_bf16 a[0:15], a[56:59], a[60:63], a[0:15]
    v_add_f32 v52, v52, v94
    v_add_f32 v53, v53, v95
    v_cvt_pk_bf16_f32 v88, v88, v89
    v_cvt_pk_bf16_f32 v89, v90, v91
    v_cvt_pk_bf16_f32 v90, v92, v93
    v_cvt_pk_bf16_f32 v91, v94, v95
    ds_write_b128 v38, v[72:75] offset:16384
    ds_write_b128 v38, v[88:91] offset:17408
    s_waitcnt lgkmcnt(5)
    v_mfma_f32_32x32x16_bf16 a[0:15], a[64:67], a[68:71], a[0:15]
    s_add_u32 m0, s71, 4096
    s_nop 0
    buffer_load_dwordx4 v9, s[28:31], s76 offen offset:3072 lds
    s_waitcnt lgkmcnt(2)
    v_mfma_f32_32x32x16_bf16 a[0:15], a[72:75], a[76:79], a[0:15]
    s_waitcnt lgkmcnt(0)
    s_barrier
    ds_read_b64_tr_b16 a[16:17], v32 offset:20480
    ds_read_b64_tr_b16 a[18:19], v32 offset:22528
    ds_read_b128 a[20:23], v42 offset:16384
    ds_read_b64_tr_b16 a[24:25], v32 offset:28672
    ds_read_b64_tr_b16 a[26:27], v32 offset:30720
    ds_read_b128 a[28:31], v42 offset:18432
    ds_read_b64_tr_b16 a[32:33], v30 offset:53248
    ds_read_b64_tr_b16 a[34:35], v30 offset:55296
    ds_read_b128 a[36:39], v42 offset:20480
    ds_read_b64_tr_b16 a[40:41], v30 offset:61440
    ds_read_b64_tr_b16 a[42:43], v30 offset:63488
    ds_read_b128 a[44:47], v42 offset:22528
    v_fma_f32 v96, v96, s57, -v48
    v_fma_f32 v97, v97, s57, -v48
    v_fma_f32 v98, v98, s57, -v48
    v_fma_f32 v99, v99, s57, -v48
    v_fma_f32 v100, v100, s57, -v48
    v_fma_f32 v101, v101, s57, -v48
    v_fma_f32 v102, v102, s57, -v48
    v_fma_f32 v103, v103, s57, -v48
    v_fma_f32 v112, v112, s57, -v49
    v_fma_f32 v113, v113, s57, -v49
    v_fma_f32 v114, v114, s57, -v49
    v_fma_f32 v115, v115, s57, -v49
    v_fma_f32 v116, v116, s57, -v49
    v_fma_f32 v117, v117, s57, -v49
    v_fma_f32 v118, v118, s57, -v49
    v_fma_f32 v119, v119, s57, -v49
    v_exp_f32 v96, v96
    v_exp_f32 v97, v97
    v_exp_f32 v98, v98
    v_exp_f32 v99, v99
    s_waitcnt lgkmcnt(9)
    ds_read_b64_tr_b16 a[48:49], v31 offset:4096
    ds_read_b64_tr_b16 a[50:51], v31 offset:6144
    ds_read_b128 a[52:55], v42 offset:24576
    v_mfma_f32_32x32x16_bf16 a[0:15], a[16:19], a[20:23], a[0:15]
    v_exp_f32 v100, v100
    v_exp_f32 v101, v101
    v_exp_f32 v102, v102
    v_exp_f32 v103, v103
    v_exp_f32 v112, v112
    v_exp_f32 v113, v113
    s_waitcnt lgkmcnt(9)
    ds_read_b64_tr_b16 a[56:57], v31 offset:12288
    ds_read_b64_tr_b16 a[58:59], v31 offset:14336
    ds_read_b128 a[60:63], v42 offset:26624
    v_mfma_f32_32x32x16_bf16 a[0:15], a[24:27], a[28:31], a[0:15]
    v_exp_f32 v114, v114
    v_exp_f32 v115, v115
    v_exp_f32 v116, v116
    v_exp_f32 v117, v117
    v_exp_f32 v118, v118
    v_exp_f32 v119, v119
    s_waitcnt lgkmcnt(9)
    ds_read_b64_tr_b16 a[64:65], v31 offset:20480
    ds_read_b64_tr_b16 a[66:67], v31 offset:22528
    ds_read_b128 a[68:71], v42 offset:28672
    v_mfma_f32_32x32x16_bf16 a[0:15], a[32:35], a[36:39], a[0:15]
    v_add_f32 v50, v50, v96
    v_add_f32 v51, v51, v97
    v_add_f32 v50, v50, v98
    v_add_f32 v51, v51, v99
    v_add_f32 v50, v50, v100
    v_add_f32 v51, v51, v101
    s_waitcnt lgkmcnt(9)
    ds_read_b64_tr_b16 a[72:73], v31 offset:28672
    ds_read_b64_tr_b16 a[74:75], v31 offset:30720
    ds_read_b128 a[76:79], v42 offset:30720
    v_mfma_f32_32x32x16_bf16 a[0:15], a[40:43], a[44:47], a[0:15]
    v_add_f32 v50, v50, v102
    v_add_f32 v51, v51, v103
    v_cvt_pk_bf16_f32 v96, v96, v97
    v_cvt_pk_bf16_f32 v97, v98, v99
    v_cvt_pk_bf16_f32 v98, v100, v101
    v_cvt_pk_bf16_f32 v99, v102, v103
    s_waitcnt lgkmcnt(9)
    v_mfma_f32_32x32x16_bf16 a[0:15], a[48:51], a[52:55], a[0:15]
    v_add_f32 v52, v52, v112
    v_add_f32 v53, v53, v113
    v_add_f32 v52, v52, v114
    v_add_f32 v53, v53, v115
    v_add_f32 v52, v52, v116
    v_add_f32 v53, v53, v117
    s_waitcnt lgkmcnt(6)
    v_mfma_f32_32x32x16_bf16 a[0:15], a[56:59], a[60:63], a[0:15]
    v_add_f32 v52, v52, v118
    v_add_f32 v53, v53, v119
    v_cvt_pk_bf16_f32 v112, v112, v113
    v_cvt_pk_bf16_f32 v113, v114, v115
    v_cvt_pk_bf16_f32 v114, v116, v117
    v_cvt_pk_bf16_f32 v115, v118, v119
    ds_write_b128 v38, v[96:99] offset:0
    ds_write_b128 v38, v[112:115] offset:1024
    s_waitcnt lgkmcnt(5)
    v_mfma_f32_32x32x16_bf16 a[0:15], a[64:67], a[68:71], a[0:15]
    s_waitcnt lgkmcnt(2)
    v_mfma_f32_32x32x16_bf16 a[0:15], a[72:75], a[76:79], a[0:15]
    s_waitcnt vmcnt(0) lgkmcnt(0)
    s_barrier
    ds_read_b64_tr_b16 a[16:17], v31 offset:32768
    ds_read_b64_tr_b16 a[18:19], v31 offset:34816
    ds_read_b128 a[20:23], v42 offset:0
    ds_read_b64_tr_b16 a[24:25], v31 offset:40960
    ds_read_b64_tr_b16 a[26:27], v31 offset:43008
    ds_read_b128 a[28:31], v42 offset:2048
    ds_read_b64_tr_b16 a[32:33], v31 offset:49152
    ds_read_b64_tr_b16 a[34:35], v31 offset:51200
    ds_read_b128 a[36:39], v42 offset:4096
    ds_read_b64_tr_b16 a[40:41], v31 offset:57344
    ds_read_b64_tr_b16 a[42:43], v31 offset:59392
    ds_read_b128 a[44:47], v42 offset:6144
    v_fma_f32 v104, v104, s57, -v48
    v_fma_f32 v105, v105, s57, -v48
    v_fma_f32 v106, v106, s57, -v48
    v_fma_f32 v107, v107, s57, -v48
    v_fma_f32 v108, v108, s57, -v48
    v_fma_f32 v109, v109, s57, -v48
    v_fma_f32 v110, v110, s57, -v48
    v_fma_f32 v111, v111, s57, -v48
    v_fma_f32 v120, v120, s57, -v49
    v_fma_f32 v121, v121, s57, -v49
    v_fma_f32 v122, v122, s57, -v49
    v_fma_f32 v123, v123, s57, -v49
    v_fma_f32 v124, v124, s57, -v49
    v_fma_f32 v125, v125, s57, -v49
    v_fma_f32 v126, v126, s57, -v49
    v_fma_f32 v127, v127, s57, -v49
    v_exp_f32 v104, v104
    v_exp_f32 v105, v105
    v_exp_f32 v106, v106
    v_exp_f32 v107, v107
    s_waitcnt lgkmcnt(9)
    ds_read_b64_tr_b16 a[48:49], v32 offset:0
    ds_read_b64_tr_b16 a[50:51], v32 offset:2048
    ds_read_b128 a[52:55], v42 offset:8192
    v_mfma_f32_32x32x16_bf16 a[0:15], a[16:19], a[20:23], a[0:15]
    v_exp_f32 v108, v108
    v_exp_f32 v109, v109
    v_exp_f32 v110, v110
    v_exp_f32 v111, v111
    v_exp_f32 v120, v120
    v_exp_f32 v121, v121
    s_waitcnt lgkmcnt(9)
    ds_read_b64_tr_b16 a[56:57], v32 offset:8192
    ds_read_b64_tr_b16 a[58:59], v32 offset:10240
    ds_read_b128 a[60:63], v42 offset:10240
    v_mfma_f32_32x32x16_bf16 a[0:15], a[24:27], a[28:31], a[0:15]
    v_exp_f32 v122, v122
    v_exp_f32 v123, v123
    v_exp_f32 v124, v124
    v_exp_f32 v125, v125
    v_exp_f32 v126, v126
    v_exp_f32 v127, v127
    s_waitcnt lgkmcnt(9)
    ds_read_b64_tr_b16 a[64:65], v30 offset:0
    ds_read_b64_tr_b16 a[66:67], v30 offset:2048
    ds_read_b128 a[68:71], v42 offset:12288
    v_mfma_f32_32x32x16_bf16 a[0:15], a[32:35], a[36:39], a[0:15]
    v_add_f32 v50, v50, v104
    v_add_f32 v51, v51, v105
    v_add_f32 v50, v50, v106
    v_add_f32 v51, v51, v107
    v_add_f32 v50, v50, v108
    v_add_f32 v51, v51, v109
    s_waitcnt lgkmcnt(9)
    ds_read_b64_tr_b16 a[72:73], v30 offset:8192
    ds_read_b64_tr_b16 a[74:75], v30 offset:10240
    ds_read_b128 a[76:79], v42 offset:14336
    v_mfma_f32_32x32x16_bf16 a[0:15], a[40:43], a[44:47], a[0:15]
    v_add_f32 v50, v50, v110
    v_add_f32 v51, v51, v111
    v_cvt_pk_bf16_f32 v104, v104, v105
    v_cvt_pk_bf16_f32 v105, v106, v107
    v_cvt_pk_bf16_f32 v106, v108, v109
    v_cvt_pk_bf16_f32 v107, v110, v111
    s_waitcnt lgkmcnt(9)
    v_mfma_f32_32x32x16_bf16 a[0:15], a[48:51], a[52:55], a[0:15]
    v_add_f32 v52, v52, v120
    v_add_f32 v53, v53, v121
    v_add_f32 v52, v52, v122
    v_add_f32 v53, v53, v123
    v_add_f32 v52, v52, v124
    v_add_f32 v53, v53, v125
    s_waitcnt lgkmcnt(6)
    v_mfma_f32_32x32x16_bf16 a[0:15], a[56:59], a[60:63], a[0:15]
    v_add_f32 v52, v52, v126
    v_add_f32 v53, v53, v127
    v_cvt_pk_bf16_f32 v120, v120, v121
    v_cvt_pk_bf16_f32 v121, v122, v123
    v_cvt_pk_bf16_f32 v122, v124, v125
    v_cvt_pk_bf16_f32 v123, v126, v127
    ds_write_b128 v38, v[104:107] offset:16384
    ds_write_b128 v38, v[120:123] offset:17408
    v_add_f32 v50, v50, v51
    v_mov_b32 v51, v50
    v_add_f32 v52, v52, v53
    v_mov_b32 v53, v52
    v_add_u32 v37, 114688, v37
    v_permlane32_swap_b32 v50, v51
    v_permlane32_swap_b32 v52, v53
    v_add_f32 v50, v50, v51
    v_add_f32 v52, v52, v53
    ds_write_b32 v37, v50 offset:0
    ds_write_b32 v37, v52 offset:1024
    s_waitcnt lgkmcnt(7)
    v_mfma_f32_32x32x16_bf16 a[0:15], a[64:67], a[68:71], a[0:15]
    s_waitcnt lgkmcnt(4)
    v_mfma_f32_32x32x16_bf16 a[0:15], a[72:75], a[76:79], a[0:15]
    s_waitcnt lgkmcnt(0)
    s_barrier
    v_add_u32 v36, 114688, v36
    v_lshl_add_u32 v36, v45, 10, v36
    ds_read_b128 v[128:131], v36 offset:0
    ds_read_b128 v[132:135], v36 offset:16
    ds_read_b64_tr_b16 a[16:17], v31 offset:36864
    ds_read_b64_tr_b16 a[18:19], v31 offset:38912
    ds_read_b128 a[20:23], v42 offset:16384
    ds_read_b64_tr_b16 a[24:25], v31 offset:45056
    ds_read_b64_tr_b16 a[26:27], v31 offset:47104
    ds_read_b128 a[28:31], v42 offset:18432
    ds_read_b64_tr_b16 a[32:33], v31 offset:53248
    ds_read_b64_tr_b16 a[34:35], v31 offset:55296
    ds_read_b128 a[36:39], v42 offset:20480
    ds_read_b64_tr_b16 a[40:41], v31 offset:61440
    ds_read_b64_tr_b16 a[42:43], v31 offset:63488
    ds_read_b128 a[44:47], v42 offset:22528
    s_lshl_b32 s58, s46, 19
    s_lshl_b32 s59, s48, 13
    s_add_u32 s58, s58, s59
    s_and_b32 s59, s49, 3
    s_lshl_b32 s59, s59, 11
    s_add_u32 s58, s58, s59
    s_lshr_b32 s59, s49, 2
    s_lshl_b32 s59, s59, 18
    s_add_u32 s58, s58, s59
    s_waitcnt lgkmcnt(9)
    ds_read_b64_tr_b16 a[48:49], v32 offset:4096
    ds_read_b64_tr_b16 a[50:51], v32 offset:6144
    ds_read_b128 a[52:55], v42 offset:24576
    v_mfma_f32_32x32x16_bf16 a[0:15], a[16:19], a[20:23], a[0:15]
    s_waitcnt lgkmcnt(9)
    ds_read_b64_tr_b16 a[56:57], v32 offset:12288
    ds_read_b64_tr_b16 a[58:59], v32 offset:14336
    ds_read_b128 a[60:63], v42 offset:26624
    v_mfma_f32_32x32x16_bf16 a[0:15], a[24:27], a[28:31], a[0:15]
    v_add_f32 v128, v128, v132
    v_add_f32 v129, v129, v133
    v_add_f32 v130, v130, v134
    v_add_f32 v131, v131, v135
    v_add_f32 v128, v128, v129
    v_add_f32 v130, v130, v131
    v_add_f32 v128, v128, v130
    v_rcp_f32 v128, v128
    s_waitcnt lgkmcnt(9)
    ds_read_b64_tr_b16 a[64:65], v30 offset:4096
    ds_read_b64_tr_b16 a[66:67], v30 offset:6144
    ds_read_b128 a[68:71], v42 offset:28672
    v_mfma_f32_32x32x16_bf16 a[0:15], a[32:35], a[36:39], a[0:15]
    s_waitcnt lgkmcnt(9)
    ds_read_b64_tr_b16 a[72:73], v30 offset:12288
    ds_read_b64_tr_b16 a[74:75], v30 offset:14336
    ds_read_b128 a[76:79], v42 offset:30720
    v_mfma_f32_32x32x16_bf16 a[0:15], a[40:43], a[44:47], a[0:15]
    s_waitcnt lgkmcnt(9)
    v_mfma_f32_32x32x16_bf16 a[0:15], a[48:51], a[52:55], a[0:15]
    s_waitcnt lgkmcnt(6)
    v_mfma_f32_32x32x16_bf16 a[0:15], a[56:59], a[60:63], a[0:15]
    s_waitcnt lgkmcnt(3)
    v_mfma_f32_32x32x16_bf16 a[0:15], a[64:67], a[68:71], a[0:15]
    s_waitcnt lgkmcnt(0)
    v_mfma_f32_32x32x16_bf16 a[0:15], a[72:75], a[76:79], a[0:15]
    s_nop 11
    v_accvgpr_read_b32 v64, a0
    v_accvgpr_read_b32 v65, a1
    v_accvgpr_read_b32 v66, a2
    v_accvgpr_read_b32 v67, a3
    v_accvgpr_read_b32 v68, a4
    v_accvgpr_read_b32 v69, a5
    v_accvgpr_read_b32 v70, a6
    v_accvgpr_read_b32 v71, a7
    v_accvgpr_read_b32 v72, a8
    v_accvgpr_read_b32 v73, a9
    v_accvgpr_read_b32 v74, a10
    v_accvgpr_read_b32 v75, a11
    v_accvgpr_read_b32 v76, a12
    v_accvgpr_read_b32 v77, a13
    v_accvgpr_read_b32 v78, a14
    v_accvgpr_read_b32 v79, a15
    v_mul_f32 v64, v64, v128
    v_mul_f32 v65, v65, v128
    v_mul_f32 v66, v66, v128
    v_mul_f32 v67, v67, v128
    v_mul_f32 v68, v68, v128
    v_mul_f32 v69, v69, v128
    v_mul_f32 v70, v70, v128
    v_mul_f32 v71, v71, v128
    v_mul_f32 v72, v72, v128
    v_mul_f32 v73, v73, v128
    v_mul_f32 v74, v74, v128
    v_mul_f32 v75, v75, v128
    v_mul_f32 v76, v76, v128
    v_mul_f32 v77, v77, v128
    v_mul_f32 v78, v78, v128
    v_mul_f32 v79, v79, v128
    v_cvt_pk_bf16_f32 v80, v64, v65
    v_cvt_pk_bf16_f32 v81, v66, v67
    v_cvt_pk_bf16_f32 v82, v68, v69
    v_cvt_pk_bf16_f32 v83, v70, v71
    v_cvt_pk_bf16_f32 v84, v72, v73
    v_cvt_pk_bf16_f32 v85, v74, v75
    v_cvt_pk_bf16_f32 v86, v76, v77
    v_cvt_pk_bf16_f32 v87, v78, v79
    buffer_store_dwordx4 v[80:83], v35, s[40:43], s58 offen sc0 sc1
    buffer_store_dwordx4 v[84:87], v35, s[40:43], s58 offen offset:1024 sc0 sc1
    s_waitcnt vmcnt(0)
L1_done:
    s_endpgm
.globl oproj_kernel
.p2align 8
.type oproj_kernel,@function
oproj_kernel:
    s_cmp_ge_u32 s2, 256
    s_cbranch_scc1 L2_done
    s_load_dwordx2 s[14:15], s[0:1], 40
    s_load_dwordx2 s[18:19], s[0:1], 56
    s_and_b32 s44, s2, 7
    s_lshr_b32 s45, s2, 3
    s_and_b32 s46, s44, 3
    s_lshl_b32 s46, s46, 2
    s_and_b32 s47, s45, 3
    s_add_u32 s46, s46, s47
    s_lshr_b32 s48, s44, 2
    s_lshl_b32 s48, s48, 3
    s_lshr_b32 s47, s45, 2
    s_add_u32 s48, s48, s47
    v_lshrrev_b32 v1, 6, v0
    v_and_b32 v2, 63, v0
    v_lshlrev_b32 v3, 4, v2
    v_lshl_add_u32 v4, v1, 16, v3
    s_waitcnt lgkmcnt(0)
    s_mov_b32 s40, s18
    s_mov_b32 s41, s19
    s_mov_b32 s42, 8388608
    s_mov_b32 s43, 0x00020000
    s_mov_b32 s36, s14
    s_mov_b32 s37, s15
    s_mov_b32 s38, 524288
    s_mov_b32 s39, 0x00020000
    s_lshl_b32 s50, s48, 18
    s_add_u32 s50, s50, 4194304
    s_lshl_b32 s51, s46, 18
    s_and_b32 s54, s45, 3
    s_lshl_b32 s54, s54, 1
    s_lshr_b32 s55, s45, 2
    s_add_u32 s54, s54, s55
    s_mov_b32 s54, 0
    s_add_u32 s56, s54, 0
    s_and_b32 s56, s56, 7
    s_lshl_b32 s56, s56, 13
    s_add_u32 s57, s56, s50
    s_add_u32 s58, s56, s51
    s_add_u32 s60, s57, 0
    s_add_u32 s61, s58, 0
    buffer_load_dwordx4 a[0:3], v4, s[40:43], s60 offen
    buffer_load_dwordx4 a[4:7], v4, s[40:43], s61 offen
    buffer_load_dwordx4 a[8:11], v4, s[40:43], s60 offen offset:1024
    buffer_load_dwordx4 a[12:15], v4, s[40:43], s61 offen offset:1024
    buffer_load_dwordx4 a[16:19], v4, s[40:43], s60 offen offset:2048
    buffer_load_dwordx4 a[20:23], v4, s[40:43], s61 offen offset:2048
    buffer_load_dwordx4 a[24:27], v4, s[40:43], s60 offen offset:3072
    buffer_load_dwordx4 a[28:31], v4, s[40:43], s61 offen offset:3072
    s_add_u32 s62, s57, 4096
    s_add_u32 s63, s58, 4096
    buffer_load_dwordx4 a[32:35], v4, s[40:43], s62 offen
    buffer_load_dwordx4 a[36:39], v4, s[40:43], s63 offen
    buffer_load_dwordx4 a[40:43], v4, s[40:43], s62 offen offset:1024
    buffer_load_dwordx4 a[44:47], v4, s[40:43], s63 offen offset:1024
    buffer_load_dwordx4 a[48:51], v4, s[40:43], s62 offen offset:2048
    buffer_load_dwordx4 a[52:55], v4, s[40:43], s63 offen offset:2048
    buffer_load_dwordx4 a[56:59], v4, s[40:43], s62 offen offset:3072
    buffer_load_dwordx4 a[60:63], v4, s[40:43], s63 offen offset:3072
    s_add_u32 s56, s54, 1
    s_and_b32 s56, s56, 7
    s_lshl_b32 s56, s56, 13
    s_add_u32 s57, s56, s50
    s_add_u32 s58, s56, s51
    s_add_u32 s60, s57, 0
    s_add_u32 s61, s58, 0
    buffer_load_dwordx4 a[64:67], v4, s[40:43], s60 offen
    buffer_load_dwordx4 a[68:71], v4, s[40:43], s61 offen
    buffer_load_dwordx4 a[72:75], v4, s[40:43], s60 offen offset:1024
    buffer_load_dwordx4 a[76:79], v4, s[40:43], s61 offen offset:1024
    buffer_load_dwordx4 a[80:83], v4, s[40:43], s60 offen offset:2048
    buffer_load_dwordx4 a[84:87], v4, s[40:43], s61 offen offset:2048
    buffer_load_dwordx4 a[88:91], v4, s[40:43], s60 offen offset:3072
    buffer_load_dwordx4 a[92:95], v4, s[40:43], s61 offen offset:3072
    s_add_u32 s62, s57, 4096
    s_add_u32 s63, s58, 4096
    buffer_load_dwordx4 a[96:99], v4, s[40:43], s62 offen
    buffer_load_dwordx4 a[100:103], v4, s[40:43], s63 offen
    buffer_load_dwordx4 a[104:107], v4, s[40:43], s62 offen offset:1024
    buffer_load_dwordx4 a[108:111], v4, s[40:43], s63 offen offset:1024
    buffer_load_dwordx4 a[112:115], v4, s[40:43], s62 offen offset:2048
    buffer_load_dwordx4 a[116:119], v4, s[40:43], s63 offen offset:2048
    buffer_load_dwordx4 a[120:123], v4, s[40:43], s62 offen offset:3072
    buffer_load_dwordx4 a[124:127], v4, s[40:43], s63 offen offset:3072
    s_add_u32 s56, s54, 2
    s_and_b32 s56, s56, 7
    s_lshl_b32 s56, s56, 13
    s_add_u32 s57, s56, s50
    s_add_u32 s58, s56, s51
    s_add_u32 s60, s57, 0
    s_add_u32 s61, s58, 0
    buffer_load_dwordx4 a[128:131], v4, s[40:43], s60 offen
    buffer_load_dwordx4 a[132:135], v4, s[40:43], s61 offen
    buffer_load_dwordx4 a[136:139], v4, s[40:43], s60 offen offset:1024
    buffer_load_dwordx4 a[140:143], v4, s[40:43], s61 offen offset:1024
    buffer_load_dwordx4 a[144:147], v4, s[40:43], s60 offen offset:2048
    buffer_load_dwordx4 a[148:151], v4, s[40:43], s61 offen offset:2048
    buffer_load_dwordx4 a[152:155], v4, s[40:43], s60 offen offset:3072
    buffer_load_dwordx4 a[156:159], v4, s[40:43], s61 offen offset:3072
    s_add_u32 s62, s57, 4096
    s_add_u32 s63, s58, 4096
    buffer_load_dwordx4 a[160:163], v4, s[40:43], s62 offen
    buffer_load_dwordx4 a[164:167], v4, s[40:43], s63 offen
    buffer_load_dwordx4 a[168:171], v4, s[40:43], s62 offen offset:1024
    buffer_load_dwordx4 a[172:175], v4, s[40:43], s63 offen offset:1024
    buffer_load_dwordx4 a[176:179], v4, s[40:43], s62 offen offset:2048
    buffer_load_dwordx4 a[180:183], v4, s[40:43], s63 offen offset:2048
    buffer_load_dwordx4 a[184:187], v4, s[40:43], s62 offen offset:3072
    buffer_load_dwordx4 a[188:191], v4, s[40:43], s63 offen offset:3072
    s_waitcnt vmcnt(46)
    s_add_u32 s56, s54, 3
    s_and_b32 s56, s56, 7
    s_lshl_b32 s56, s56, 13
    s_add_u32 s57, s56, s50
    s_add_u32 s58, s56, s51
    s_add_u32 s60, s57, 0
    s_add_u32 s61, s58, 0
    buffer_load_dwordx4 a[192:195], v4, s[40:43], s60 offen
    buffer_load_dwordx4 a[196:199], v4, s[40:43], s61 offen
    buffer_load_dwordx4 a[200:203], v4, s[40:43], s60 offen offset:1024
    buffer_load_dwordx4 a[204:207], v4, s[40:43], s61 offen offset:1024
    buffer_load_dwordx4 a[208:211], v4, s[40:43], s60 offen offset:2048
    buffer_load_dwordx4 a[212:215], v4, s[40:43], s61 offen offset:2048
    buffer_load_dwordx4 a[216:219], v4, s[40:43], s60 offen offset:3072
    buffer_load_dwordx4 a[220:223], v4, s[40:43], s61 offen offset:3072
    s_add_u32 s62, s57, 4096
    s_add_u32 s63, s58, 4096
    buffer_load_dwordx4 a[224:227], v4, s[40:43], s62 offen
    buffer_load_dwordx4 a[228:231], v4, s[40:43], s63 offen
    buffer_load_dwordx4 a[232:235], v4, s[40:43], s62 offen offset:1024
    buffer_load_dwordx4 a[236:239], v4, s[40:43], s63 offen offset:1024
    buffer_load_dwordx4 a[240:243], v4, s[40:43], s62 offen offset:2048
    buffer_load_dwordx4 a[244:247], v4, s[40:43], s63 offen offset:2048
    buffer_load_dwordx4 a[248:251], v4, s[40:43], s62 offen offset:3072
    buffer_load_dwordx4 a[252:255], v4, s[40:43], s63 offen offset:3072
    v_mfma_f32_32x32x16_bf16 v[16:31], a[0:3], a[4:7], 0
    s_waitcnt vmcnt(60)
    v_mfma_f32_32x32x16_bf16 v[16:31], a[8:11], a[12:15], v[16:31]
    s_waitcnt vmcnt(58)
    v_mfma_f32_32x32x16_bf16 v[16:31], a[16:19], a[20:23], v[16:31]
    s_waitcnt vmcnt(56)
    v_mfma_f32_32x32x16_bf16 v[16:31], a[24:27], a[28:31], v[16:31]
    s_waitcnt vmcnt(54)
    v_mfma_f32_32x32x16_bf16 v[16:31], a[32:35], a[36:39], v[16:31]
    s_waitcnt vmcnt(52)
    v_mfma_f32_32x32x16_bf16 v[16:31], a[40:43], a[44:47], v[16:31]
    s_waitcnt vmcnt(50)
    v_mfma_f32_32x32x16_bf16 v[16:31], a[48:51], a[52:55], v[16:31]
    s_waitcnt vmcnt(48)
    v_mfma_f32_32x32x16_bf16 v[16:31], a[56:59], a[60:63], v[16:31]
    s_waitcnt vmcnt(46)
    s_add_u32 s56, s54, 4
    s_and_b32 s56, s56, 7
    s_lshl_b32 s56, s56, 13
    s_add_u32 s57, s56, s50
    s_add_u32 s58, s56, s51
    s_add_u32 s60, s57, 0
    s_add_u32 s61, s58, 0
    buffer_load_dwordx4 a[0:3], v4, s[40:43], s60 offen
    buffer_load_dwordx4 a[4:7], v4, s[40:43], s61 offen
    buffer_load_dwordx4 a[8:11], v4, s[40:43], s60 offen offset:1024
    buffer_load_dwordx4 a[12:15], v4, s[40:43], s61 offen offset:1024
    buffer_load_dwordx4 a[16:19], v4, s[40:43], s60 offen offset:2048
    buffer_load_dwordx4 a[20:23], v4, s[40:43], s61 offen offset:2048
    buffer_load_dwordx4 a[24:27], v4, s[40:43], s60 offen offset:3072
    buffer_load_dwordx4 a[28:31], v4, s[40:43], s61 offen offset:3072
    s_add_u32 s62, s57, 4096
    s_add_u32 s63, s58, 4096
    buffer_load_dwordx4 a[32:35], v4, s[40:43], s62 offen
    buffer_load_dwordx4 a[36:39], v4, s[40:43], s63 offen
    buffer_load_dwordx4 a[40:43], v4, s[40:43], s62 offen offset:1024
    buffer_load_dwordx4 a[44:47], v4, s[40:43], s63 offen offset:1024
    buffer_load_dwordx4 a[48:51], v4, s[40:43], s62 offen offset:2048
    buffer_load_dwordx4 a[52:55], v4, s[40:43], s63 offen offset:2048
    buffer_load_dwordx4 a[56:59], v4, s[40:43], s62 offen offset:3072
    buffer_load_dwordx4 a[60:63], v4, s[40:43], s63 offen offset:3072
    v_mfma_f32_32x32x16_bf16 v[16:31], a[64:67], a[68:71], v[16:31]
    s_waitcnt vmcnt(60)
    v_mfma_f32_32x32x16_bf16 v[16:31], a[72:75], a[76:79], v[16:31]
    s_waitcnt vmcnt(58)
    v_mfma_f32_32x32x16_bf16 v[16:31], a[80:83], a[84:87], v[16:31]
    s_waitcnt vmcnt(56)
    v_mfma_f32_32x32x16_bf16 v[16:31], a[88:91], a[92:95], v[16:31]
    s_waitcnt vmcnt(54)
    v_mfma_f32_32x32x16_bf16 v[16:31], a[96:99], a[100:103], v[16:31]
    s_waitcnt vmcnt(52)
    v_mfma_f32_32x32x16_bf16 v[16:31], a[104:107], a[108:111], v[16:31]
    s_waitcnt vmcnt(50)
    v_mfma_f32_32x32x16_bf16 v[16:31], a[112:115], a[116:119], v[16:31]
    s_waitcnt vmcnt(48)
    v_mfma_f32_32x32x16_bf16 v[16:31], a[120:123], a[124:127], v[16:31]
    s_waitcnt vmcnt(46)
    s_add_u32 s56, s54, 5
    s_and_b32 s56, s56, 7
    s_lshl_b32 s56, s56, 13
    s_add_u32 s57, s56, s50
    s_add_u32 s58, s56, s51
    s_add_u32 s60, s57, 0
    s_add_u32 s61, s58, 0
    buffer_load_dwordx4 a[64:67], v4, s[40:43], s60 offen
    buffer_load_dwordx4 a[68:71], v4, s[40:43], s61 offen
    buffer_load_dwordx4 a[72:75], v4, s[40:43], s60 offen offset:1024
    buffer_load_dwordx4 a[76:79], v4, s[40:43], s61 offen offset:1024
    buffer_load_dwordx4 a[80:83], v4, s[40:43], s60 offen offset:2048
    buffer_load_dwordx4 a[84:87], v4, s[40:43], s61 offen offset:2048
    buffer_load_dwordx4 a[88:91], v4, s[40:43], s60 offen offset:3072
    buffer_load_dwordx4 a[92:95], v4, s[40:43], s61 offen offset:3072
    s_add_u32 s62, s57, 4096
    s_add_u32 s63, s58, 4096
    buffer_load_dwordx4 a[96:99], v4, s[40:43], s62 offen
    buffer_load_dwordx4 a[100:103], v4, s[40:43], s63 offen
    buffer_load_dwordx4 a[104:107], v4, s[40:43], s62 offen offset:1024
    buffer_load_dwordx4 a[108:111], v4, s[40:43], s63 offen offset:1024
    buffer_load_dwordx4 a[112:115], v4, s[40:43], s62 offen offset:2048
    buffer_load_dwordx4 a[116:119], v4, s[40:43], s63 offen offset:2048
    buffer_load_dwordx4 a[120:123], v4, s[40:43], s62 offen offset:3072
    buffer_load_dwordx4 a[124:127], v4, s[40:43], s63 offen offset:3072
    v_mfma_f32_32x32x16_bf16 v[16:31], a[128:131], a[132:135], v[16:31]
    s_waitcnt vmcnt(60)
    v_mfma_f32_32x32x16_bf16 v[16:31], a[136:139], a[140:143], v[16:31]
    s_waitcnt vmcnt(58)
    v_mfma_f32_32x32x16_bf16 v[16:31], a[144:147], a[148:151], v[16:31]
    s_waitcnt vmcnt(56)
    v_mfma_f32_32x32x16_bf16 v[16:31], a[152:155], a[156:159], v[16:31]
    s_waitcnt vmcnt(54)
    v_mfma_f32_32x32x16_bf16 v[16:31], a[160:163], a[164:167], v[16:31]
    s_waitcnt vmcnt(52)
    v_mfma_f32_32x32x16_bf16 v[16:31], a[168:171], a[172:175], v[16:31]
    s_waitcnt vmcnt(50)
    v_mfma_f32_32x32x16_bf16 v[16:31], a[176:179], a[180:183], v[16:31]
    s_waitcnt vmcnt(48)
    v_mfma_f32_32x32x16_bf16 v[16:31], a[184:187], a[188:191], v[16:31]
    s_waitcnt vmcnt(46)
    s_add_u32 s56, s54, 6
    s_and_b32 s56, s56, 7
    s_lshl_b32 s56, s56, 13
    s_add_u32 s57, s56, s50
    s_add_u32 s58, s56, s51
    s_add_u32 s60, s57, 0
    s_add_u32 s61, s58, 0
    buffer_load_dwordx4 a[128:131], v4, s[40:43], s60 offen
    buffer_load_dwordx4 a[132:135], v4, s[40:43], s61 offen
    buffer_load_dwordx4 a[136:139], v4, s[40:43], s60 offen offset:1024
    buffer_load_dwordx4 a[140:143], v4, s[40:43], s61 offen offset:1024
    buffer_load_dwordx4 a[144:147], v4, s[40:43], s60 offen offset:2048
    buffer_load_dwordx4 a[148:151], v4, s[40:43], s61 offen offset:2048
    buffer_load_dwordx4 a[152:155], v4, s[40:43], s60 offen offset:3072
    buffer_load_dwordx4 a[156:159], v4, s[40:43], s61 offen offset:3072
    s_add_u32 s62, s57, 4096
    s_add_u32 s63, s58, 4096
    buffer_load_dwordx4 a[160:163], v4, s[40:43], s62 offen
    buffer_load_dwordx4 a[164:167], v4, s[40:43], s63 offen
    buffer_load_dwordx4 a[168:171], v4, s[40:43], s62 offen offset:1024
    buffer_load_dwordx4 a[172:175], v4, s[40:43], s63 offen offset:1024
    buffer_load_dwordx4 a[176:179], v4, s[40:43], s62 offen offset:2048
    buffer_load_dwordx4 a[180:183], v4, s[40:43], s63 offen offset:2048
    buffer_load_dwordx4 a[184:187], v4, s[40:43], s62 offen offset:3072
    buffer_load_dwordx4 a[188:191], v4, s[40:43], s63 offen offset:3072
    v_mfma_f32_32x32x16_bf16 v[16:31], a[192:195], a[196:199], v[16:31]
    s_waitcnt vmcnt(60)
    v_mfma_f32_32x32x16_bf16 v[16:31], a[200:203], a[204:207], v[16:31]
    s_waitcnt vmcnt(58)
    v_mfma_f32_32x32x16_bf16 v[16:31], a[208:211], a[212:215], v[16:31]
    s_waitcnt vmcnt(56)
    v_mfma_f32_32x32x16_bf16 v[16:31], a[216:219], a[220:223], v[16:31]
    s_waitcnt vmcnt(54)
    v_mfma_f32_32x32x16_bf16 v[16:31], a[224:227], a[228:231], v[16:31]
    s_waitcnt vmcnt(52)
    v_mfma_f32_32x32x16_bf16 v[16:31], a[232:235], a[236:239], v[16:31]
    s_waitcnt vmcnt(50)
    v_mfma_f32_32x32x16_bf16 v[16:31], a[240:243], a[244:247], v[16:31]
    s_waitcnt vmcnt(48)
    v_mfma_f32_32x32x16_bf16 v[16:31], a[248:251], a[252:255], v[16:31]
    s_waitcnt vmcnt(46)
    s_add_u32 s56, s54, 7
    s_and_b32 s56, s56, 7
    s_lshl_b32 s56, s56, 13
    s_add_u32 s57, s56, s50
    s_add_u32 s58, s56, s51
    s_add_u32 s60, s57, 0
    s_add_u32 s61, s58, 0
    buffer_load_dwordx4 a[192:195], v4, s[40:43], s60 offen
    buffer_load_dwordx4 a[196:199], v4, s[40:43], s61 offen
    buffer_load_dwordx4 a[200:203], v4, s[40:43], s60 offen offset:1024
    buffer_load_dwordx4 a[204:207], v4, s[40:43], s61 offen offset:1024
    buffer_load_dwordx4 a[208:211], v4, s[40:43], s60 offen offset:2048
    buffer_load_dwordx4 a[212:215], v4, s[40:43], s61 offen offset:2048
    buffer_load_dwordx4 a[216:219], v4, s[40:43], s60 offen offset:3072
    buffer_load_dwordx4 a[220:223], v4, s[40:43], s61 offen offset:3072
    s_add_u32 s62, s57, 4096
    s_add_u32 s63, s58, 4096
    buffer_load_dwordx4 a[224:227], v4, s[40:43], s62 offen
    buffer_load_dwordx4 a[228:231], v4, s[40:43], s63 offen
    buffer_load_dwordx4 a[232:235], v4, s[40:43], s62 offen offset:1024
    buffer_load_dwordx4 a[236:239], v4, s[40:43], s63 offen offset:1024
    buffer_load_dwordx4 a[240:243], v4, s[40:43], s62 offen offset:2048
    buffer_load_dwordx4 a[244:247], v4, s[40:43], s63 offen offset:2048
    buffer_load_dwordx4 a[248:251], v4, s[40:43], s62 offen offset:3072
    buffer_load_dwordx4 a[252:255], v4, s[40:43], s63 offen offset:3072
    v_mfma_f32_32x32x16_bf16 v[16:31], a[0:3], a[4:7], v[16:31]
    s_waitcnt vmcnt(60)
    v_mfma_f32_32x32x16_bf16 v[16:31], a[8:11], a[12:15], v[16:31]
    s_waitcnt vmcnt(58)
    v_mfma_f32_32x32x16_bf16 v[16:31], a[16:19], a[20:23], v[16:31]
    s_waitcnt vmcnt(56)
    v_mfma_f32_32x32x16_bf16 v[16:31], a[24:27], a[28:31], v[16:31]
    s_waitcnt vmcnt(54)
    v_mfma_f32_32x32x16_bf16 v[16:31], a[32:35], a[36:39], v[16:31]
    s_waitcnt vmcnt(52)
    v_mfma_f32_32x32x16_bf16 v[16:31], a[40:43], a[44:47], v[16:31]
    s_waitcnt vmcnt(50)
    v_mfma_f32_32x32x16_bf16 v[16:31], a[48:51], a[52:55], v[16:31]
    s_waitcnt vmcnt(48)
    v_mfma_f32_32x32x16_bf16 v[16:31], a[56:59], a[60:63], v[16:31]
    s_waitcnt vmcnt(46)
    v_mfma_f32_32x32x16_bf16 v[16:31], a[64:67], a[68:71], v[16:31]
    s_waitcnt vmcnt(44)
    v_mfma_f32_32x32x16_bf16 v[16:31], a[72:75], a[76:79], v[16:31]
    s_waitcnt vmcnt(42)
    v_mfma_f32_32x32x16_bf16 v[16:31], a[80:83], a[84:87], v[16:31]
    s_waitcnt vmcnt(40)
    v_mfma_f32_32x32x16_bf16 v[16:31], a[88:91], a[92:95], v[16:31]
    s_waitcnt vmcnt(38)
    v_mfma_f32_32x32x16_bf16 v[16:31], a[96:99], a[100:103], v[16:31]
    s_waitcnt vmcnt(36)
    v_mfma_f32_32x32x16_bf16 v[16:31], a[104:107], a[108:111], v[16:31]
    s_waitcnt vmcnt(34)
    v_mfma_f32_32x32x16_bf16 v[16:31], a[112:115], a[116:119], v[16:31]
    s_waitcnt vmcnt(32)
    v_mfma_f32_32x32x16_bf16 v[16:31], a[120:123], a[124:127], v[16:31]
    s_waitcnt vmcnt(30)
    v_mfma_f32_32x32x16_bf16 v[16:31], a[128:131], a[132:135], v[16:31]
    s_waitcnt vmcnt(28)
    v_mfma_f32_32x32x16_bf16 v[16:31], a[136:139], a[140:143], v[16:31]
    s_waitcnt vmcnt(26)
    v_mfma_f32_32x32x16_bf16 v[16:31], a[144:147], a[148:151], v[16:31]
    s_waitcnt vmcnt(24)
    v_mfma_f32_32x32x16_bf16 v[16:31], a[152:155], a[156:159], v[16:31]
    s_waitcnt vmcnt(22)
    v_mfma_f32_32x32x16_bf16 v[16:31], a[160:163], a[164:167], v[16:31]
    s_waitcnt vmcnt(20)
    v_mfma_f32_32x32x16_bf16 v[16:31], a[168:171], a[172:175], v[16:31]
    s_waitcnt vmcnt(18)
    v_mfma_f32_32x32x16_bf16 v[16:31], a[176:179], a[180:183], v[16:31]
    s_waitcnt vmcnt(16)
    v_mfma_f32_32x32x16_bf16 v[16:31], a[184:187], a[188:191], v[16:31]
    s_waitcnt vmcnt(14)
    v_mfma_f32_32x32x16_bf16 v[16:31], a[192:195], a[196:199], v[16:31]
    s_waitcnt vmcnt(12)
    v_mfma_f32_32x32x16_bf16 v[16:31], a[200:203], a[204:207], v[16:31]
    s_waitcnt vmcnt(10)
    v_mfma_f32_32x32x16_bf16 v[16:31], a[208:211], a[212:215], v[16:31]
    s_waitcnt vmcnt(8)
    v_mfma_f32_32x32x16_bf16 v[16:31], a[216:219], a[220:223], v[16:31]
    s_waitcnt vmcnt(6)
    v_mfma_f32_32x32x16_bf16 v[16:31], a[224:227], a[228:231], v[16:31]
    s_waitcnt vmcnt(4)
    v_mfma_f32_32x32x16_bf16 v[16:31], a[232:235], a[236:239], v[16:31]
    s_waitcnt vmcnt(2)
    v_mfma_f32_32x32x16_bf16 v[16:31], a[240:243], a[244:247], v[16:31]
    s_waitcnt vmcnt(0)
    v_mfma_f32_32x32x16_bf16 v[16:31], a[248:251], a[252:255], v[16:31]
    v_lshl_add_u32 v5, v1, 12, v3
    s_nop 10
    ds_write_b128 v5, v[16:19] offset:0
    ds_write_b128 v5, v[20:23] offset:1024
    ds_write_b128 v5, v[24:27] offset:2048
    ds_write_b128 v5, v[28:31] offset:3072
    s_waitcnt lgkmcnt(0)
    s_barrier
    v_lshl_add_u32 v5, v1, 10, v3
    ds_read_b128 v[32:35], v5 offset:0
    ds_read_b128 v[36:39], v5 offset:4096
    ds_read_b128 v[40:43], v5 offset:8192
    ds_read_b128 v[44:47], v5 offset:12288
    v_and_b32 v6, 31, v2
    v_lshrrev_b32 v7, 5, v2
    v_lshlrev_b32 v6, 10, v6
    v_lshl_add_u32 v6, v7, 3, v6
    v_lshl_add_u32 v6, v1, 4, v6
    s_lshl_b32 s52, s46, 15
    s_lshl_b32 s53, s48, 6
    s_add_u32 s52, s52, s53
    s_waitcnt lgkmcnt(0)
    v_add_f32 v32, v32, v36
    v_add_f32 v40, v40, v44
    v_add_f32 v33, v33, v37
    v_add_f32 v41, v41, v45
    v_add_f32 v34, v34, v38
    v_add_f32 v42, v42, v46
    v_add_f32 v35, v35, v39
    v_add_f32 v43, v43, v47
    v_add_f32 v32, v32, v40
    v_add_f32 v33, v33, v41
    v_add_f32 v34, v34, v42
    v_add_f32 v35, v35, v43
    v_cvt_pk_bf16_f32 v48, v32, v33
    v_cvt_pk_bf16_f32 v49, v34, v35
    buffer_store_dwordx2 v[48:49], v6, s[36:39], s52 offen
L2_done:
    s_endpgm
.section .rodata,"a"
.p2align 6
.amdhsa_kernel attn_kernel
  .amdhsa_next_free_vgpr 256
  .amdhsa_next_free_sgpr 102
  .amdhsa_accum_offset 144
  .amdhsa_group_segment_fixed_size 0
  .amdhsa_kernarg_size 64
  .amdhsa_user_sgpr_count 2
  .amdhsa_user_sgpr_kernarg_segment_ptr 1
  .amdhsa_system_sgpr_workgroup_id_x 1
.end_amdhsa_kernel
.p2align 6
.amdhsa_kernel oproj_kernel
  .amdhsa_next_free_vgpr 320
  .amdhsa_next_free_sgpr 102
  .amdhsa_accum_offset 64
  .amdhsa_group_segment_fixed_size 0
  .amdhsa_kernarg_size 64
  .amdhsa_user_sgpr_count 2
  .amdhsa_user_sgpr_kernarg_segment_ptr 1
  .amdhsa_system_sgpr_workgroup_id_x 1
.end_amdhsa_kernel
```
